```python
import torch

def _softmax(x, axis=-1):
    return torch.softmax(x, dim=axis)
def _gelu(x):
    return torch.nn.functional.gelu(x, approximate="tanh")
def _silu(x):
    return torch.nn.functional.silu(x)
def _sigmoid(x):
    return torch.sigmoid(x)
def _layernorm(x, axis=-1, eps=1e-5):
    m = x.mean(dim=axis, keepdim=True)
    v = x.var(dim=axis, keepdim=True, unbiased=False)
    return (x - m) / torch.sqrt(v + eps)
def _scatter_add(tgt, idx, src, axis=0):
    return tgt.clone().index_add_(axis, idx, src)
def _segment_sum(src, seg, n):
    out = torch.zeros((n,) + src.shape[1:], dtype=src.dtype)
    return out.index_add_(0, seg, src)
def _pad(x, pw):
    flat = tuple(v for pair in reversed(pw) for v in pair)
    return torch.nn.functional.pad(x, flat)

kernel_name = 'gated_mix__sliding_block_cached__swiglu_ffn__decode'

def setup_inputs():

    _w = (lambda a: (lambda t: t.to(torch.bfloat16) if t.is_floating_point() else t)(torch.as_tensor(a)))
    def _A_setup():
        B, Sq, D = 2, 1, 640
        Hq, Hkv, Sk, Dh = 32, 32, 8192, 192
        assert Hq % Hkv == 0, (Hq, Hkv)
        return {
            "x": _w((lambda *s: torch.randn(*s, dtype=torch.bfloat16) * 0.05)(B, Sq, D)),
            "k_cache": _w((lambda *s: torch.randn(*s, dtype=torch.bfloat16) * 6.4)(B, Hkv, Sk, Dh)),
            "v_cache": _w((lambda *s: torch.randn(*s, dtype=torch.bfloat16) * 0.4)(B, Hkv, Sk, Dh)),
            "wq": _w((lambda *s: torch.randn(*s, dtype=torch.bfloat16) * 6.4)(D, Hq * Dh) * (D ** -0.5)),
            "wo": _w((lambda *s: torch.randn(*s, dtype=torch.bfloat16) * 0.4)(Hq * Dh, D) * ((Hq * Dh) ** -0.5)),
        }
    _A_in = _A_setup()

    def _B_setup():
        B, S, D, F = 2, 1, 640, 1536
        return {
            "x": _w((lambda *s: torch.randn(*s, dtype=torch.bfloat16) * 0.05)(B, S, D)),
            "w_gate": _w((lambda *s: torch.randn(*s, dtype=torch.bfloat16) * 0.05)(D, F)),
            "w_up": _w((lambda *s: torch.randn(*s, dtype=torch.bfloat16) * 0.05)(D, F)),
            "w_down": _w((lambda *s: torch.randn(*s, dtype=torch.bfloat16) * 0.05)(F, D)),
        }
    _B_in = _B_setup()

    return {
        "A_x": _A_in["x"],
        "A_k_cache": _A_in["k_cache"],
        "A_v_cache": _A_in["v_cache"],
        "A_wq": _A_in["wq"],
        "A_wo": _A_in["wo"],
        "B_x": _B_in["x"],
        "B_w_gate": _B_in["w_gate"],
        "B_w_up": _B_in["w_up"],
        "B_w_down": _B_in["w_down"],
        "gate_w": _w((lambda *s: torch.randn(*s, dtype=torch.bfloat16) * 0.05)(640) * 16.0),
    }

def reference(A_x, A_k_cache, A_v_cache, A_wq, A_wo, B_x, B_w_gate, B_w_up, B_w_down, gate_w):
    def _A_ref(x, k_cache, v_cache, wq, wo):
        B, Sq, D = x.shape
        Hq, Dh = 32, 192
        Hkv, Sk = k_cache.shape[1], k_cache.shape[2]
        W = min(4096, max(256, Sk // 4))
        rep = Hq // Hkv
        q = (lambda x, *d: x.permute(*d))((x @ wq).reshape(B, Sq, Hq, Dh), 0, 2, 1, 3)
        k = (lambda x, n, axis: torch.repeat_interleave(x, n, dim=axis))(k_cache[:, :, Sk - W:, :], rep, axis=1)
        v = (lambda x, n, axis: torch.repeat_interleave(x, n, dim=axis))(v_cache[:, :, Sk - W:, :], rep, axis=1)
        scores = torch.einsum("bhqd,bhkd->bhqk", q, k) * (Dh ** -0.5)
        p = _softmax(scores, axis=-1)
        o = torch.einsum("bhqk,bhkd->bhqd", p, v)
        return (lambda x, *d: x.permute(*d))(o, 0, 2, 1, 3).reshape(B, Sq, Hq * Dh) @ wo

    def _B_ref(x, w_gate, w_up, w_down):
        g = _silu(x @ w_gate)
        u = x @ w_up
        return (g * u) @ w_down

    x = A_x
    g = _sigmoid((x * gate_w).sum(-1, keepdims=True))
    a = _A_ref(x, A_k_cache, A_v_cache, A_wq, A_wo)
    b = _B_ref(x, B_w_gate, B_w_up, B_w_down)
    return g * a + (1 - g) * b
```

```asm
; @launch grid=(256,1,1) block=(512,1,1) lds=38912
.amdgcn_target "amdgcn-amd-amdhsa--gfx950"
.text
.globl gated_mix__sliding_block_cached__swiglu_ffn__decode_kernel
.p2align 8
.type gated_mix__sliding_block_cached__swiglu_ffn__decode_kernel,@function
gated_mix__sliding_block_cached__swiglu_ffn__decode_kernel:
    s_cmp_ge_u32 s2, 256
    s_cbranch_scc1 L_end
    s_load_dwordx16 s[8:23], s[0:1], 0
    s_getpc_b64 s[60:61]
L_pc:
    s_and_b32 s3, s2, 8
    s_lshl_b32 s3, s3, 9
    v_lshl_add_u32 v4, v0, 3, s3
    v_min_u32 v4, L_end-L_pc, v4
    global_load_dword v200, v4, s[60:61]
    v_lshrrev_b32 v4, 6, v0
    v_bfe_u32 v8, v0, 3, 3
    v_and_b32 v9, 7, v0
    v_mul_u32_u24 v2, 24576, v4
    v_mul_u32_u24 v5, 384, v8
    v_lshl_add_u32 v2, v9, 4, v2
    v_add_u32 v2, v5, v2
    s_and_b32 s3, s2, 7
    s_lshr_b32 s5, s2, 6
    s_lshl2_add_u32 s5, s3, s5
    s_lshr_b32 s6, s2, 3
    s_and_b32 s6, s6, 7
    s_lshr_b32 s7, s6, 2
    s_and_b32 s3, s6, 3
    s_lshl_b32 s34, s7, 5
    s_add_u32 s34, s34, s5
    s_lshl4_add_u32 s34, s34, s3
    s_add_u32 s34, s34, 12
    s_mul_i32 s34, s34, 196608
    s_waitcnt lgkmcnt(0)
    s_add_u32 s36, s10, s34
    s_addc_u32 s37, s11, 0
    global_load_dwordx4 v[16:19], v2, s[36:37] offset:0 nt
    global_load_dwordx4 v[20:23], v2, s[36:37] offset:128 nt
    global_load_dwordx4 v[24:27], v2, s[36:37] offset:256 nt
    global_load_dwordx4 v[28:31], v2, s[36:37] offset:3072 nt
    s_load_dwordx8 s[24:31], s[0:1], 64
    s_load_dwordx2 s[32:33], s[0:1], 96
    v_and_b32 v1, 63, v0
    v_readfirstlane_b32 s4, v4
    s_mul_i32 s3, s6, 80
    s_mul_i32 s35, s4, 10
    s_add_u32 s35, s35, s3
    s_mul_i32 s3, s35, 12288
    s_mul_i32 s62, s5, 384
    s_add_u32 s3, s3, s62
    s_add_u32 s14, s14, s3
    s_addc_u32 s15, s15, 0
    s_mul_i32 s3, s35, 3072
    s_mul_i32 s62, s5, 96
    s_add_u32 s3, s3, s62
    s_add_u32 s20, s20, s3
    s_addc_u32 s21, s21, 0
    s_sub_u32 s20, s20, 384
    s_subb_u32 s21, s21, 0
    s_add_u32 s22, s22, s3
    s_addc_u32 s23, s23, 0
    s_sub_u32 s22, s22, 480
    s_subb_u32 s23, s23, 0
    v_mov_b32 v170, s14
    v_mov_b32 v171, s15
    v_mov_b32 v172, 0x3000
    v_mov_b32 v173, 0
    s_mov_b32 exec_lo, 0xff000000
    v_mov_b32 v170, s20
    v_mov_b32 v171, s21
    v_mov_b32 v172, 0xc00
    s_mov_b32 exec_lo, 0xc0000000
    v_mov_b32 v170, s22
    v_mov_b32 v171, s23
    s_mov_b32 exec_lo, -1
    s_mov_b32 exec_hi, 0xf
    v_lshlrev_b32 v4, 4, v1
    v_add_co_u32 v170, vcc, v170, v4
    s_nop 1
    v_addc_co_u32 v171, vcc, 0, v171, vcc
    global_load_dwordx4 v[112:115], v[170:171], off
    v_lshl_add_u64 v[170:171], v[172:173], 0, v[170:171]
    global_load_dwordx4 v[116:119], v[170:171], off
    v_lshl_add_u64 v[170:171], v[172:173], 0, v[170:171]
    global_load_dwordx4 v[120:123], v[170:171], off
    v_lshl_add_u64 v[170:171], v[172:173], 0, v[170:171]
    global_load_dwordx4 v[124:127], v[170:171], off
    v_lshl_add_u64 v[170:171], v[172:173], 0, v[170:171]
    global_load_dwordx4 v[128:131], v[170:171], off
    v_lshl_add_u64 v[170:171], v[172:173], 0, v[170:171]
    global_load_dwordx4 v[132:135], v[170:171], off
    v_lshl_add_u64 v[170:171], v[172:173], 0, v[170:171]
    s_mov_b64 exec, -1
    s_and_b32 s37, s37, 0xffff
    s_mov_b32 s38, 196608
    s_mov_b32 s39, 0x20000
    s_mov_b32 s68, 0
    s_mov_b32 s69, 3072
    s_mov_b32 s70, 6144
    s_mov_b32 s71, 9216
    s_mov_b32 s72, 12288
    s_mov_b32 s73, 15360
    s_mov_b32 s74, 18432
    s_mov_b32 s75, 21504
    s_mov_b32 s42, s38
    s_mov_b32 s43, s39
    s_mov_b32 s54, 2097152
    s_mov_b32 s55, s39
    s_mov_b32 s89, 200000
    s_waitcnt lgkmcnt(0)
    s_mov_b32 s52, s32
    s_and_b32 s53, s33, 0xffff
    s_load_dword s81, s[32:33], 0
    s_lshl_b32 s3, s35, 1
    s_add_u32 s60, s8, s3
    s_addc_u32 s61, s9, 0
    s_load_dwordx4 s[76:79], s[60:61], 0
    s_load_dword s80, s[60:61], 16
    s_load_dwordx4 s[84:87], s[60:61], 1280
    s_load_dword s88, s[60:61], 1296
    s_add_u32 s40, s12, s34
    s_addc_u32 s41, s13, 0
    s_and_b32 s41, s41, 0xffff
    s_mul_i32 s3, s5, 245760
    s_mul_i32 s62, s6, 160
    s_add_u32 s3, s3, s62
    s_add_u32 s44, s16, s3
    s_addc_u32 s45, s17, 0
    s_and_b32 s45, s45, 0xffff
    s_sub_u32 s46, 245760, s62
    s_mov_b32 s47, 0x20000
    s_mul_i32 s3, s5, 61440
    s_add_u32 s3, s3, s62
    s_add_u32 s48, s24, s3
    s_addc_u32 s49, s25, 0
    s_and_b32 s49, s49, 0xffff
    s_sub_u32 s50, 61440, s62
    s_mov_b32 s51, 0x20000
    s_mov_b32 s56, s28
    s_and_b32 s57, s29, 0xffff
    s_mov_b32 s58, 2560
    s_mov_b32 s59, 0x20000
    s_mov_b32 s92, 0x05040100
    s_mov_b32 s93, 0x07060302
    s_lshl_b32 s94, s5, 3
    s_add_u32 s94, s94, s6
    v_lshlrev_b32 v174, 5, v1
    s_mul_i32 s3, s4, 2304
    v_add_u32 v174, s3, v174
    v_add_u32 v175, 768, v174
    s_mov_b32 exec_lo, 0xff000000
    v_add_u32 v174, 768, v174
    v_add_u32 v175, 384, v175
    s_mov_b32 exec_lo, -1
    v_mov_b32 v152, 0
    v_mov_b32 v153, 0
    v_mov_b32 v154, 0
    v_mov_b32 v155, 0
    v_mov_b32 v156, 0
    v_mov_b32 v157, 0
    v_mov_b32 v158, 0
    v_mov_b32 v159, 0
    v_mov_b32 v160, 0
    v_mov_b32 v161, 0
    v_mov_b32 v162, 0
    v_mov_b32 v163, 0
    v_mov_b32 v164, 0
    v_mov_b32 v165, 0
    v_mov_b32 v166, 0
    v_mov_b32 v167, 0
    s_waitcnt lgkmcnt(0)
    s_mov_b32 exec_hi, 0xf
    s_waitcnt vmcnt(4)
    v_perm_b32 v168, v116, v112, s92
    v_perm_b32 v169, v116, v112, s93
    v_dot2c_f32_bf16 v152, s76, v168
    v_dot2c_f32_bf16 v160, s84, v168
    v_dot2c_f32_bf16 v153, s76, v169
    v_dot2c_f32_bf16 v161, s84, v169
    v_perm_b32 v192, v117, v113, s92
    v_perm_b32 v193, v117, v113, s93
    v_dot2c_f32_bf16 v154, s76, v192
    v_dot2c_f32_bf16 v162, s84, v192
    v_dot2c_f32_bf16 v155, s76, v193
    v_dot2c_f32_bf16 v163, s84, v193
    v_perm_b32 v168, v118, v114, s92
    v_perm_b32 v169, v118, v114, s93
    v_dot2c_f32_bf16 v156, s76, v168
    v_dot2c_f32_bf16 v164, s84, v168
    v_dot2c_f32_bf16 v157, s76, v169
    v_dot2c_f32_bf16 v165, s84, v169
    v_perm_b32 v192, v119, v115, s92
    v_perm_b32 v193, v119, v115, s93
    v_dot2c_f32_bf16 v158, s76, v192
    v_dot2c_f32_bf16 v166, s84, v192
    v_dot2c_f32_bf16 v159, s76, v193
    v_dot2c_f32_bf16 v167, s84, v193
    global_load_dwordx4 v[136:139], v[170:171], off
    v_lshl_add_u64 v[170:171], v[172:173], 0, v[170:171]
    global_load_dwordx4 v[140:143], v[170:171], off
    v_lshl_add_u64 v[170:171], v[172:173], 0, v[170:171]
    s_waitcnt vmcnt(4)
    v_perm_b32 v168, v124, v120, s92
    v_perm_b32 v169, v124, v120, s93
    v_dot2c_f32_bf16 v152, s77, v168
    v_dot2c_f32_bf16 v160, s85, v168
    v_dot2c_f32_bf16 v153, s77, v169
    v_dot2c_f32_bf16 v161, s85, v169
    v_perm_b32 v192, v125, v121, s92
    v_perm_b32 v193, v125, v121, s93
    v_dot2c_f32_bf16 v154, s77, v192
    v_dot2c_f32_bf16 v162, s85, v192
    v_dot2c_f32_bf16 v155, s77, v193
    v_dot2c_f32_bf16 v163, s85, v193
    v_perm_b32 v168, v126, v122, s92
    v_perm_b32 v169, v126, v122, s93
    v_dot2c_f32_bf16 v156, s77, v168
    v_dot2c_f32_bf16 v164, s85, v168
    v_dot2c_f32_bf16 v157, s77, v169
    v_dot2c_f32_bf16 v165, s85, v169
    v_perm_b32 v192, v127, v123, s92
    v_perm_b32 v193, v127, v123, s93
    v_dot2c_f32_bf16 v158, s77, v192
    v_dot2c_f32_bf16 v166, s85, v192
    v_dot2c_f32_bf16 v159, s77, v193
    v_dot2c_f32_bf16 v167, s85, v193
    global_load_dwordx4 v[144:147], v[170:171], off
    v_lshl_add_u64 v[170:171], v[172:173], 0, v[170:171]
    global_load_dwordx4 v[148:151], v[170:171], off
    s_waitcnt vmcnt(4)
    v_perm_b32 v168, v132, v128, s92
    v_perm_b32 v169, v132, v128, s93
    v_dot2c_f32_bf16 v152, s78, v168
    v_dot2c_f32_bf16 v160, s86, v168
    v_dot2c_f32_bf16 v153, s78, v169
    v_dot2c_f32_bf16 v161, s86, v169
    v_perm_b32 v192, v133, v129, s92
    v_perm_b32 v193, v133, v129, s93
    v_dot2c_f32_bf16 v154, s78, v192
    v_dot2c_f32_bf16 v162, s86, v192
    v_dot2c_f32_bf16 v155, s78, v193
    v_dot2c_f32_bf16 v163, s86, v193
    v_perm_b32 v168, v134, v130, s92
    v_perm_b32 v169, v134, v130, s93
    v_dot2c_f32_bf16 v156, s78, v168
    v_dot2c_f32_bf16 v164, s86, v168
    v_dot2c_f32_bf16 v157, s78, v169
    v_dot2c_f32_bf16 v165, s86, v169
    v_perm_b32 v192, v135, v131, s92
    v_perm_b32 v193, v135, v131, s93
    v_dot2c_f32_bf16 v158, s78, v192
    v_dot2c_f32_bf16 v166, s86, v192
    v_dot2c_f32_bf16 v159, s78, v193
    v_dot2c_f32_bf16 v167, s86, v193
    s_mov_b32 exec_hi, -1
    buffer_load_dwordx4 v[32:35], v2, s[36:39], s69 offen offset:128 nt
    buffer_load_dwordx4 v[36:39], v2, s[36:39], s69 offen offset:256 nt
    s_mov_b32 exec_hi, 0xf
    s_waitcnt vmcnt(4)
    v_perm_b32 v168, v140, v136, s92
    v_perm_b32 v169, v140, v136, s93
    v_dot2c_f32_bf16 v152, s79, v168
    v_dot2c_f32_bf16 v160, s87, v168
    v_dot2c_f32_bf16 v153, s79, v169
    v_dot2c_f32_bf16 v161, s87, v169
    v_perm_b32 v192, v141, v137, s92
    v_perm_b32 v193, v141, v137, s93
    v_dot2c_f32_bf16 v154, s79, v192
    v_dot2c_f32_bf16 v162, s87, v192
    v_dot2c_f32_bf16 v155, s79, v193
    v_dot2c_f32_bf16 v163, s87, v193
    v_perm_b32 v168, v142, v138, s92
    v_perm_b32 v169, v142, v138, s93
    v_dot2c_f32_bf16 v156, s79, v168
    v_dot2c_f32_bf16 v164, s87, v168
    v_dot2c_f32_bf16 v157, s79, v169
    v_dot2c_f32_bf16 v165, s87, v169
    v_perm_b32 v192, v143, v139, s92
    v_perm_b32 v193, v143, v139, s93
    v_dot2c_f32_bf16 v158, s79, v192
    v_dot2c_f32_bf16 v166, s87, v192
    v_dot2c_f32_bf16 v159, s79, v193
    v_dot2c_f32_bf16 v167, s87, v193
    s_mov_b32 exec_hi, -1
    buffer_load_dwordx4 v[40:43], v2, s[36:39], s70 offen offset:0 nt
    buffer_load_dwordx4 v[44:47], v2, s[36:39], s70 offen offset:128 nt
    s_mov_b32 exec_hi, 0xf
    s_waitcnt vmcnt(4)
    v_perm_b32 v168, v148, v144, s92
    v_perm_b32 v169, v148, v144, s93
    v_dot2c_f32_bf16 v152, s80, v168
    v_dot2c_f32_bf16 v160, s88, v168
    v_dot2c_f32_bf16 v153, s80, v169
    v_dot2c_f32_bf16 v161, s88, v169
    v_perm_b32 v192, v149, v145, s92
    v_perm_b32 v193, v149, v145, s93
    v_dot2c_f32_bf16 v154, s80, v192
    v_dot2c_f32_bf16 v162, s88, v192
    v_dot2c_f32_bf16 v155, s80, v193
    v_dot2c_f32_bf16 v163, s88, v193
    v_perm_b32 v168, v150, v146, s92
    v_perm_b32 v169, v150, v146, s93
    v_dot2c_f32_bf16 v156, s80, v168
    v_dot2c_f32_bf16 v164, s88, v168
    v_dot2c_f32_bf16 v157, s80, v169
    v_dot2c_f32_bf16 v165, s88, v169
    v_perm_b32 v192, v151, v147, s92
    v_perm_b32 v193, v151, v147, s93
    v_dot2c_f32_bf16 v158, s80, v192
    v_dot2c_f32_bf16 v166, s88, v192
    v_dot2c_f32_bf16 v159, s80, v193
    v_dot2c_f32_bf16 v167, s88, v193
    s_mov_b32 exec_hi, -1
    buffer_load_dwordx4 v[48:51], v2, s[36:39], s70 offen offset:256 nt
    buffer_load_dwordx4 v[52:55], v2, s[36:39], s71 offen offset:0 nt
    s_mov_b32 exec_hi, 0xf
    ds_write_b128 v174, v[152:155] offset:0
    ds_write_b128 v174, v[156:159] offset:16
    ds_write_b128 v175, v[160:163] offset:0
    ds_write_b128 v175, v[164:167] offset:16
    s_mov_b32 exec_hi, -1
    s_add_u32 s81, s81, 0x9e3779b9
    s_getreg_b32 s82, hwreg(HW_REG_XCC_ID)
    v_mov_b32 v3, s81
    s_waitcnt lgkmcnt(0)
    s_barrier
    s_mul_i32 s3, s4, 24
    v_add_u32 v5, s3, v1
    v_lshrrev_b32 v4, 6, v5
    v_mul_u32_u24 v4, 768, v4
    v_and_b32 v6, 63, v5
    v_lshl_add_u32 v4, v6, 2, v4
    s_mov_b32 exec_lo, 0xffffff
    s_mov_b32 exec_hi, 0
    ds_read2st64_b32 v[112:113], v4 offset0:0 offset1:1
    ds_read2st64_b32 v[114:115], v4 offset0:2 offset1:9
    ds_read2st64_b32 v[116:117], v4 offset0:10 offset1:11
    ds_read2st64_b32 v[118:119], v4 offset0:18 offset1:19
    ds_read2st64_b32 v[120:121], v4 offset0:20 offset1:27
    ds_read2st64_b32 v[122:123], v4 offset0:28 offset1:29
    ds_read2st64_b32 v[124:125], v4 offset0:36 offset1:37
    ds_read2st64_b32 v[126:127], v4 offset0:38 offset1:45
    ds_read2st64_b32 v[128:129], v4 offset0:46 offset1:47
    ds_read2st64_b32 v[130:131], v4 offset0:54 offset1:55
    ds_read2st64_b32 v[132:133], v4 offset0:56 offset1:63
    ds_read2st64_b32 v[134:135], v4 offset0:64 offset1:65
    s_mul_i32 s3, s94, 3072
    s_add_u32 s3, s3, 65536
    v_lshlrev_b32 v5, 4, v5
    v_mov_b32 v139, v3
    s_waitcnt lgkmcnt(0)
    v_add_f32 v112, v112, v115
    v_add_f32 v113, v113, v116
    v_add_f32 v114, v114, v117
    v_add_f32 v118, v118, v121
    v_add_f32 v119, v119, v122
    v_add_f32 v120, v120, v123
    v_add_f32 v124, v124, v127
    v_add_f32 v125, v125, v128
    v_add_f32 v126, v126, v129
    v_add_f32 v130, v130, v133
    v_add_f32 v131, v131, v134
    v_add_f32 v132, v132, v135
    v_add_f32 v112, v112, v118
    v_add_f32 v113, v113, v119
    v_add_f32 v114, v114, v120
    v_add_f32 v124, v124, v130
    v_add_f32 v125, v125, v131
    v_add_f32 v126, v126, v132
    v_add_f32 v136, v112, v124
    v_add_f32 v137, v113, v125
    v_add_f32 v138, v114, v126
    buffer_store_dwordx4 v[136:139], v5, s[52:55], s3 offen sc1 nt
    s_mov_b64 exec, -1
    buffer_load_dwordx4 v[56:59], v2, s[36:39], s71 offen offset:128 nt
    buffer_load_dwordx4 v[60:63], v2, s[36:39], s71 offen offset:256 nt
    v_mul_u32_u24 v10, 3072, v8
    s_lshl_b32 s3, s4, 7
    v_lshl_add_u32 v11, v9, 4, s3
    v_add_u32 v10, v10, v11
    s_mul_i32 s95, s5, 24576
    s_add_u32 s95, s95, 65536
    s_lshl_b32 s3, s7, 10
    s_add_u32 s96, s95, s3
    s_mov_b32 s60, s8
    s_and_b32 s61, s9, 0xffff
    s_mov_b32 s62, 2560
    s_mov_b32 s63, 0x20000
    s_mov_b32 s64, s26
    s_and_b32 s65, s27, 0xffff
    s_mov_b32 s66, 1280
    s_mov_b32 s67, 0x20000
    s_mul_i32 s3, s4, 160
    v_and_b32 v4, 31, v1
    v_lshl_add_u32 v5, v4, 3, s3
    v_lshrrev_b32 v6, 5, v1
    v_mul_u32_u24 v6, 1280, v6
    v_add_u32 v6, v5, v6
    v_cmp_lt_u32 vcc, 19, v4
    v_mov_b32 v7, 0x10000
    s_nop 0
    v_cndmask_b32 v5, v5, v7, vcc
    buffer_load_dwordx2 v[176:177], v6, s[60:63], 0 offen
    buffer_load_dwordx2 v[178:179], v5, s[64:67], 0 offen
    s_waitcnt vmcnt(7)
    s_bitcmp1_b32 0xf0, s4
    s_cbranch_scc1 L_y1
    s_waitcnt vmcnt(6)
L_y1:
    buffer_load_dwordx4 v[64:67], v2, s[36:39], s72 offen offset:0 nt
    v_and_b32 v12, 1, v9
    v_lshlrev_b32 v12, 4, v12
    v_mov_b32 v13, 0xffff
    v_lshlrev_b32 v13, v12, v13
    v_lshrrev_b32 v12, 1, v9
    v_cmp_eq_u32 vcc, 0, v12
    s_nop 1
    v_cndmask_b32 v4, 0, v13, vcc
    v_cmp_eq_u32 vcc, 1, v12
    s_nop 1
    v_cndmask_b32 v5, 0, v13, vcc
    v_cmp_eq_u32 vcc, 2, v12
    s_nop 1
    v_cndmask_b32 v6, 0, v13, vcc
    v_cmp_eq_u32 vcc, 3, v12
    s_nop 1
    v_cndmask_b32 v7, 0, v13, vcc
    v_lshrrev_b32 v12, 5, v1
    v_mul_u32_u24 v12, 768, v12
    v_bfe_u32 v13, v1, 4, 1
    v_and_b32 v14, 8, v1
    v_cmp_ne_u32 vcc, 0, v14
    s_nop 1
    v_cndmask_b32 v13, v13, 2, vcc
    v_lshl_add_u32 v12, v13, 8, v12
    v_lshl_add_u32 v12, v9, 2, v12
    s_lshl_b32 s3, s4, 5
    v_add_u32 v12, s3, v12
    v_mov_b32 v232, 0
    v_mov_b32 v233, 0
    v_mov_b32 v234, 0
    v_mov_b32 v235, 0
    v_mov_b32 v236, 0
    v_mov_b32 v237, 0
    v_mov_b32 v238, 0
    v_mov_b32 v239, 0
    s_waitcnt vmcnt(7)
    s_bitcmp1_b32 0xf0, s4
    s_cbranch_scc1 L_y2
    s_waitcnt vmcnt(6)
L_y2:
    buffer_load_dwordx4 v[68:71], v2, s[36:39], s72 offen offset:128 nt
    s_waitcnt vmcnt(7)
    s_bitcmp1_b32 0xf0, s4
    s_cbranch_scc1 L_y3
    s_waitcnt vmcnt(5)
L_y3:
    buffer_load_dwordx4 v[72:75], v2, s[36:39], s72 offen offset:256 nt
    s_waitcnt vmcnt(6)
    s_bitcmp1_b32 0xf0, s4
    s_cbranch_scc1 L_y4
    s_waitcnt vmcnt(5)
L_y4:
    buffer_load_dwordx4 v[76:79], v2, s[36:39], s73 offen offset:0 nt
    s_waitcnt vmcnt(6)
    s_bitcmp1_b32 0xf0, s4
    s_cbranch_scc1 L_y5
    s_waitcnt vmcnt(3)
L_y5:
    buffer_load_dwordx4 v[80:83], v2, s[36:39], s73 offen offset:128 nt
    s_waitcnt vmcnt(4)
    s_bitcmp1_b32 0xf0, s4
    s_cbranch_scc1 L_y6
    s_waitcnt vmcnt(3)
L_y6:
    buffer_load_dwordx4 v[84:87], v2, s[36:39], s73 offen offset:256 nt
    s_waitcnt vmcnt(4)
    s_bitcmp1_b32 0xf0, s4
    s_cbranch_scc1 L_y7
    s_waitcnt vmcnt(3)
L_y7:
    buffer_load_dwordx4 v[88:91], v2, s[36:39], s74 offen offset:0 nt
    s_waitcnt vmcnt(4)
    s_bitcmp1_b32 0xf0, s4
    s_cbranch_scc1 L_y8
    s_waitcnt vmcnt(3)
L_y8:
    buffer_load_dwordx4 v[92:95], v2, s[36:39], s74 offen offset:128 nt
    buffer_load_dwordx4 v[240:243], v10, s[52:55], s96 offen sc1
    buffer_load_dwordx4 v[244:247], v10, s[52:55], s95 offen offset:2048 sc1
    s_waitcnt vmcnt(10)
    v_lshlrev_b32 v180, 16, v176
    v_and_b32 v181, 0xffff0000, v176
    v_lshlrev_b32 v182, 16, v178
    v_and_b32 v183, 0xffff0000, v178
    v_mul_f32 v180, v180, v182
    v_mul_f32 v181, v181, v183
    v_cvt_pk_bf16_f32 v180, v180, v181
    v_and_b32 v185, 0xffff0000, v180
    v_lshlrev_b32 v184, 16, v180
    v_lshlrev_b32 v180, 16, v177
    v_and_b32 v181, 0xffff0000, v177
    v_lshlrev_b32 v182, 16, v179
    v_and_b32 v183, 0xffff0000, v179
    v_mul_f32 v180, v180, v182
    v_mul_f32 v181, v181, v183
    v_cvt_pk_bf16_f32 v180, v180, v181
    v_and_b32 v187, 0xffff0000, v180
    v_lshlrev_b32 v186, 16, v180
    v_lshrrev_b32 v189, 5, v1
    s_lshl_b32 s3, s4, 2
    v_lshl_add_u32 v189, v189, 5, s3
    v_add_f32 v184, v184, v185
    v_add_f32 v186, v186, v187
    v_add_f32 v184, v184, v186
    s_nop 1
    v_add_f32_dpp v184, v184, v184 row_ror:8 row_mask:0xf bank_mask:0xf
    s_nop 1
    v_add_f32_dpp v184, v184, v184 row_ror:4 row_mask:0xf bank_mask:0xf
    s_nop 1
    v_add_f32_dpp v184, v184, v184 quad_perm:[2,3,0,1] row_mask:0xf bank_mask:0xf
    s_nop 1
    v_add_f32_dpp v184, v184, v184 quad_perm:[1,0,3,2] row_mask:0xf bank_mask:0xf
    v_mov_b32 v185, v184
    s_nop 1
    v_permlane16_swap_b32 v184, v185
    v_add_f32 v184, v184, v185
    s_mov_b32 exec_lo, 1
    s_mov_b32 exec_hi, 1
    ds_write_b32 v189, v184 offset:19968
    s_mov_b64 exec, -1
    s_waitcnt vmcnt(6)
    s_bitcmp1_b32 0xf0, s4
    s_cbranch_scc1 L_y9
    s_waitcnt vmcnt(5)
L_y9:
    buffer_load_dwordx4 v[96:99], v2, s[36:39], s74 offen offset:256 nt
    s_waitcnt vmcnt(6)
    s_bitcmp1_b32 0xf0, s4
    s_cbranch_scc1 L_y10
    s_waitcnt vmcnt(5)
L_y10:
    buffer_load_dwordx4 v[100:103], v2, s[36:39], s75 offen offset:0 nt
    s_waitcnt vmcnt(2)
L_chk0:
    v_cmp_ne_u32 vcc, v243, v3
    v_cmp_ne_u32 s[98:99], v247, v3
    s_or_b64 vcc, vcc, s[98:99]
    s_cbranch_vccz L_ok0
    buffer_load_dwordx4 v[240:243], v10, s[52:55], s96 offen sc1
    buffer_load_dwordx4 v[244:247], v10, s[52:55], s95 offen offset:2048 sc1
    s_waitcnt vmcnt(0)
    s_sub_u32 s89, s89, 1
    s_cbranch_scc1 L_end
    s_branch L_chk0
L_ok0:
    v_permlane32_swap_b32 v240, v244
    v_permlane32_swap_b32 v241, v245
    v_permlane32_swap_b32 v242, v246
    v_add_f32 v240, v240, v244
    v_add_f32 v241, v241, v245
    v_add_f32 v242, v242, v246
    v_mov_b32 v243, v242
    v_permlane16_swap_b32 v240, v241
    s_nop 0
    v_permlane16_swap_b32 v242, v243
    v_add_f32 v240, v240, v241
    v_add_f32 v242, v242, v243
    s_nop 0
    v_add_f32_dpp v244, v240, v240 row_ror:8 row_mask:0xf bank_mask:0x3
    s_nop 1
    v_add_f32_dpp v244, v242, v242 row_ror:8 row_mask:0xf bank_mask:0xc
    ds_write_b32 v12, v244 offset:18432
    v_lshlrev_b32 v13, 5, v9
    v_min_u32 v14, 5, v8
    s_mul_i32 s3, s4, 6
    v_add_u32 v14, s3, v14
    v_bfe_u32 v15, v1, 2, 1
    v_mul_u32_u24 v11, 96, v15
    v_add_lshl_u32 v14, v14, v11, 2
    v_lshlrev_b32 v15, 5, v15
    buffer_load_dwordx4 v[104:107], v2, s[36:39], s75 offen offset:128 nt
    buffer_load_dwordx4 v[108:111], v2, s[36:39], s75 offen offset:256 nt
    s_waitcnt lgkmcnt(0)
    s_barrier
    ds_read_b128 v[240:243], v13 offset:18432
    ds_read_b128 v[244:247], v13 offset:18448
    ds_read_b128 v[220:223], v13 offset:18688
    ds_read_b128 v[224:227], v13 offset:18704
    ds_read_b128 v[228:231], v13 offset:18944
    ds_read_b128 v[248:251], v13 offset:18960
    ds_read_b32 v10, v14 offset:19200
    ds_read_b32 v11, v14 offset:19392
    ds_read_b128 v[192:195], v15 offset:19968
    ds_read_b128 v[196:199], v15 offset:19984
    s_waitcnt vmcnt(6)
    s_bitcmp1_b32 0xf0, s4
    s_cbranch_scc1 L_y11
    s_waitcnt vmcnt(3)
L_y11:
    buffer_load_dwordx4 v[112:115], v2, s[40:43], s68 offen offset:0 nt
    s_waitcnt lgkmcnt(0)
    v_cvt_pk_bf16_f32 v208, v240, v241
    v_cvt_pk_bf16_f32 v209, v242, v243
    v_cvt_pk_bf16_f32 v210, v244, v245
    v_cvt_pk_bf16_f32 v211, v246, v247
    v_cvt_pk_bf16_f32 v212, v220, v221
    v_cvt_pk_bf16_f32 v213, v222, v223
    v_cvt_pk_bf16_f32 v214, v224, v225
    v_cvt_pk_bf16_f32 v215, v226, v227
    v_cvt_pk_bf16_f32 v216, v228, v229
    v_cvt_pk_bf16_f32 v217, v230, v231
    v_cvt_pk_bf16_f32 v218, v248, v249
    v_cvt_pk_bf16_f32 v219, v250, v251
    v_add_f32 v192, v192, v193
    v_add_f32 v194, v194, v195
    v_add_f32 v196, v196, v197
    v_add_f32 v198, v198, v199
    v_add_f32 v192, v192, v194
    v_add_f32 v196, v196, v198
    v_add_f32 v252, v192, v196
    v_cvt_pk_bf16_f32 v252, v252, v252
    v_and_b32 v252, 0xffff0000, v252
    v_mul_f32 v252, 0xbfb8aa3b, v252
    v_exp_f32 v252, v252
    s_nop 0
    v_add_f32 v252, 1.0, v252
    v_rcp_f32 v252, v252
    s_nop 0
    v_cvt_pk_bf16_f32 v252, v252, v252
    v_and_b32 v252, 0xffff0000, v252
    v_sub_f32 v253, 1.0, v252
    v_cvt_pk_bf16_f32 v253, v253, v253
    v_and_b32 v253, 0xffff0000, v253
    v_cvt_pk_bf16_f32 v10, v10, v10
    v_and_b32 v10, 0xffff0000, v10
    v_cvt_pk_bf16_f32 v11, v11, v11
    v_and_b32 v11, 0xffff0000, v11
    v_mul_f32 v12, 0xbfb8aa3b, v10
    v_exp_f32 v12, v12
    s_nop 0
    v_add_f32 v12, 1.0, v12
    v_rcp_f32 v12, v12
    s_nop 0
    v_mul_f32 v10, v10, v12
    v_cvt_pk_bf16_f32 v10, v10, v10
    v_and_b32 v10, 0xffff0000, v10
    v_mul_f32 v10, v10, v11
    v_cvt_pk_bf16_f32 v10, v10, v10
    v_and_b32 v10, 0xffff0000, v10
    v_mul_f32 v10, v10, v253
    v_mov_b32 v11, v252
    s_waitcnt vmcnt(4)
    s_bitcmp1_b32 0xf0, s4
    s_cbranch_scc1 L_y12
    s_waitcnt vmcnt(3)
L_y12:
    buffer_load_dwordx4 v[116:119], v2, s[40:43], s68 offen offset:128 nt
    s_waitcnt vmcnt(25)
    v_dot2c_f32_bf16 v232, v16, v208
    v_dot2c_f32_bf16 v233, v28, v208
    v_dot2c_f32_bf16 v232, v17, v209
    v_dot2c_f32_bf16 v233, v29, v209
    v_dot2c_f32_bf16 v232, v18, v210
    v_dot2c_f32_bf16 v233, v30, v210
    v_dot2c_f32_bf16 v232, v19, v211
    v_dot2c_f32_bf16 v233, v31, v211
    v_dot2c_f32_bf16 v232, v20, v212
    v_dot2c_f32_bf16 v233, v32, v212
    v_dot2c_f32_bf16 v232, v21, v213
    v_dot2c_f32_bf16 v233, v33, v213
    v_dot2c_f32_bf16 v232, v22, v214
    v_dot2c_f32_bf16 v233, v34, v214
    v_dot2c_f32_bf16 v232, v23, v215
    v_dot2c_f32_bf16 v233, v35, v215
    v_dot2c_f32_bf16 v232, v24, v216
    v_dot2c_f32_bf16 v233, v36, v216
    v_dot2c_f32_bf16 v232, v25, v217
    v_dot2c_f32_bf16 v233, v37, v217
    v_dot2c_f32_bf16 v232, v26, v218
    v_dot2c_f32_bf16 v233, v38, v218
    v_dot2c_f32_bf16 v232, v27, v219
    v_dot2c_f32_bf16 v233, v39, v219
    s_waitcnt vmcnt(4)
    s_bitcmp1_b32 0xf0, s4
    s_cbranch_scc1 L_y13
    s_waitcnt vmcnt(3)
L_y13:
    buffer_load_dwordx4 v[120:123], v2, s[40:43], s68 offen offset:256 nt
    s_waitcnt vmcnt(19)
    v_dot2c_f32_bf16 v234, v40, v208
    v_dot2c_f32_bf16 v235, v52, v208
    v_dot2c_f32_bf16 v234, v41, v209
    v_dot2c_f32_bf16 v235, v53, v209
    v_dot2c_f32_bf16 v234, v42, v210
    v_dot2c_f32_bf16 v235, v54, v210
    v_dot2c_f32_bf16 v234, v43, v211
    v_dot2c_f32_bf16 v235, v55, v211
    v_dot2c_f32_bf16 v234, v44, v212
    v_dot2c_f32_bf16 v235, v56, v212
    v_dot2c_f32_bf16 v234, v45, v213
    v_dot2c_f32_bf16 v235, v57, v213
    v_dot2c_f32_bf16 v234, v46, v214
    v_dot2c_f32_bf16 v235, v58, v214
    v_dot2c_f32_bf16 v234, v47, v215
    v_dot2c_f32_bf16 v235, v59, v215
    v_dot2c_f32_bf16 v234, v48, v216
    v_dot2c_f32_bf16 v235, v60, v216
    v_dot2c_f32_bf16 v234, v49, v217
    v_dot2c_f32_bf16 v235, v61, v217
    v_dot2c_f32_bf16 v234, v50, v218
    v_dot2c_f32_bf16 v235, v62, v218
    v_dot2c_f32_bf16 v234, v51, v219
    v_dot2c_f32_bf16 v235, v63, v219
    s_waitcnt vmcnt(4)
    s_bitcmp1_b32 0xf0, s4
    s_cbranch_scc1 L_y14
    s_waitcnt vmcnt(3)
L_y14:
    buffer_load_dwordx4 v[124:127], v2, s[40:43], s69 offen offset:0 nt
    s_waitcnt vmcnt(12)
    v_dot2c_f32_bf16 v236, v64, v208
    v_dot2c_f32_bf16 v237, v76, v208
    v_dot2c_f32_bf16 v236, v65, v209
    v_dot2c_f32_bf16 v237, v77, v209
    v_dot2c_f32_bf16 v236, v66, v210
    v_dot2c_f32_bf16 v237, v78, v210
    v_dot2c_f32_bf16 v236, v67, v211
    v_dot2c_f32_bf16 v237, v79, v211
    v_dot2c_f32_bf16 v236, v68, v212
    v_dot2c_f32_bf16 v237, v80, v212
    v_dot2c_f32_bf16 v236, v69, v213
    v_dot2c_f32_bf16 v237, v81, v213
    v_dot2c_f32_bf16 v236, v70, v214
    v_dot2c_f32_bf16 v237, v82, v214
    v_dot2c_f32_bf16 v236, v71, v215
    v_dot2c_f32_bf16 v237, v83, v215
    v_dot2c_f32_bf16 v236, v72, v216
    v_dot2c_f32_bf16 v237, v84, v216
    v_dot2c_f32_bf16 v236, v73, v217
    v_dot2c_f32_bf16 v237, v85, v217
    v_dot2c_f32_bf16 v236, v74, v218
    v_dot2c_f32_bf16 v237, v86, v218
    v_dot2c_f32_bf16 v236, v75, v219
    v_dot2c_f32_bf16 v237, v87, v219
    s_waitcnt vmcnt(4)
    s_bitcmp1_b32 0xf0, s4
    s_cbranch_scc1 L_y15
    s_waitcnt vmcnt(3)
L_y15:
    buffer_load_dwordx4 v[128:131], v2, s[40:43], s69 offen offset:128 nt
    s_waitcnt vmcnt(5)
    v_dot2c_f32_bf16 v238, v88, v208
    v_dot2c_f32_bf16 v239, v100, v208
    v_dot2c_f32_bf16 v238, v89, v209
    v_dot2c_f32_bf16 v239, v101, v209
    v_dot2c_f32_bf16 v238, v90, v210
    v_dot2c_f32_bf16 v239, v102, v210
    v_dot2c_f32_bf16 v238, v91, v211
    v_dot2c_f32_bf16 v239, v103, v211
    v_dot2c_f32_bf16 v238, v92, v212
    v_dot2c_f32_bf16 v239, v104, v212
    v_dot2c_f32_bf16 v238, v93, v213
    v_dot2c_f32_bf16 v239, v105, v213
    v_dot2c_f32_bf16 v238, v94, v214
    v_dot2c_f32_bf16 v239, v106, v214
    v_dot2c_f32_bf16 v238, v95, v215
    v_dot2c_f32_bf16 v239, v107, v215
    v_dot2c_f32_bf16 v238, v96, v216
    v_dot2c_f32_bf16 v239, v108, v216
    v_dot2c_f32_bf16 v238, v97, v217
    v_dot2c_f32_bf16 v239, v109, v217
    v_dot2c_f32_bf16 v238, v98, v218
    v_dot2c_f32_bf16 v239, v110, v218
    v_dot2c_f32_bf16 v238, v99, v219
    v_dot2c_f32_bf16 v239, v111, v219
    v_add_f32_dpp v232, v232, v232 quad_perm:[1,0,3,2] row_mask:0xf bank_mask:0xf
    v_add_f32_dpp v233, v233, v233 quad_perm:[1,0,3,2] row_mask:0xf bank_mask:0xf
    v_add_f32_dpp v234, v234, v234 quad_perm:[1,0,3,2] row_mask:0xf bank_mask:0xf
    v_add_f32_dpp v235, v235, v235 quad_perm:[1,0,3,2] row_mask:0xf bank_mask:0xf
    v_add_f32_dpp v236, v236, v236 quad_perm:[1,0,3,2] row_mask:0xf bank_mask:0xf
    v_add_f32_dpp v237, v237, v237 quad_perm:[1,0,3,2] row_mask:0xf bank_mask:0xf
    v_add_f32_dpp v238, v238, v238 quad_perm:[1,0,3,2] row_mask:0xf bank_mask:0xf
    v_add_f32_dpp v239, v239, v239 quad_perm:[1,0,3,2] row_mask:0xf bank_mask:0xf
    v_add_f32_dpp v232, v232, v232 quad_perm:[2,3,0,1] row_mask:0xf bank_mask:0xf
    v_add_f32_dpp v233, v233, v233 quad_perm:[2,3,0,1] row_mask:0xf bank_mask:0xf
    v_add_f32_dpp v234, v234, v234 quad_perm:[2,3,0,1] row_mask:0xf bank_mask:0xf
    v_add_f32_dpp v235, v235, v235 quad_perm:[2,3,0,1] row_mask:0xf bank_mask:0xf
    v_add_f32_dpp v236, v236, v236 quad_perm:[2,3,0,1] row_mask:0xf bank_mask:0xf
    v_add_f32_dpp v237, v237, v237 quad_perm:[2,3,0,1] row_mask:0xf bank_mask:0xf
    v_add_f32_dpp v238, v238, v238 quad_perm:[2,3,0,1] row_mask:0xf bank_mask:0xf
    v_add_f32_dpp v239, v239, v239 quad_perm:[2,3,0,1] row_mask:0xf bank_mask:0xf
    v_add_f32_dpp v232, v232, v232 row_half_mirror row_mask:0xf bank_mask:0xf
    v_add_f32_dpp v233, v233, v233 row_half_mirror row_mask:0xf bank_mask:0xf
    v_add_f32_dpp v234, v234, v234 row_half_mirror row_mask:0xf bank_mask:0xf
    v_add_f32_dpp v235, v235, v235 row_half_mirror row_mask:0xf bank_mask:0xf
    v_add_f32_dpp v236, v236, v236 row_half_mirror row_mask:0xf bank_mask:0xf
    v_add_f32_dpp v237, v237, v237 row_half_mirror row_mask:0xf bank_mask:0xf
    v_add_f32_dpp v238, v238, v238 row_half_mirror row_mask:0xf bank_mask:0xf
    v_add_f32_dpp v239, v239, v239 row_half_mirror row_mask:0xf bank_mask:0xf
    s_waitcnt vmcnt(4)
    s_bitcmp1_b32 0xf0, s4
    s_cbranch_scc1 L_y16
    s_waitcnt vmcnt(3)
L_y16:
    buffer_load_dwordx4 v[132:135], v2, s[40:43], s69 offen offset:256 nt
    v_cvt_pk_bf16_f32 v240, v232, v233
    v_cvt_pk_bf16_f32 v241, v234, v235
    v_cvt_pk_bf16_f32 v242, v236, v237
    v_cvt_pk_bf16_f32 v243, v238, v239
    v_lshlrev_b32 v232, 16, v240
    v_and_b32 v233, 0xffff0000, v240
    v_lshlrev_b32 v234, 16, v241
    v_and_b32 v235, 0xffff0000, v241
    v_lshlrev_b32 v236, 16, v242
    v_and_b32 v237, 0xffff0000, v242
    v_lshlrev_b32 v238, 16, v243
    v_and_b32 v239, 0xffff0000, v243
    v_mul_f32 v232, 0x3d93cd3a, v232
    v_mul_f32 v233, 0x3d93cd3a, v233
    v_mul_f32 v234, 0x3d93cd3a, v234
    v_mul_f32 v235, 0x3d93cd3a, v235
    v_mul_f32 v236, 0x3d93cd3a, v236
    v_mul_f32 v237, 0x3d93cd3a, v237
    v_mul_f32 v238, 0x3d93cd3a, v238
    v_mul_f32 v239, 0x3d93cd3a, v239
    v_cvt_pk_bf16_f32 v240, v232, v233
    v_cvt_pk_bf16_f32 v241, v234, v235
    v_cvt_pk_bf16_f32 v242, v236, v237
    v_cvt_pk_bf16_f32 v243, v238, v239
    v_lshlrev_b32 v232, 16, v240
    v_and_b32 v233, 0xffff0000, v240
    v_lshlrev_b32 v234, 16, v241
    v_and_b32 v235, 0xffff0000, v241
    v_lshlrev_b32 v236, 16, v242
    v_and_b32 v237, 0xffff0000, v242
    v_lshlrev_b32 v238, 16, v243
    v_and_b32 v239, 0xffff0000, v243
    v_max3_f32 v240, v232, v233, v234
    v_max3_f32 v241, v235, v236, v237
    v_max3_f32 v240, v240, v238, v239
    v_max_f32 v240, v240, v241
    s_nop 1
    v_max_f32_dpp v240, v240, v240 row_ror:8 row_mask:0xf bank_mask:0xf
    v_mov_b32 v241, v240
    s_nop 1
    v_permlane16_swap_b32 v240, v241
    v_max_f32 v240, v240, v241
    v_mov_b32 v241, v240
    s_nop 1
    v_permlane32_swap_b32 v240, v241
    v_max_f32 v240, v240, v241
    s_lshl_b32 s3, s4, 2
    v_mov_b32 v14, s3
    v_mov_b32 v15, 0
    s_mov_b64 exec, 1
    ds_write_b32 v14, v240 offset:20032
    s_mov_b64 exec, -1
    buffer_load_dwordx4 v[136:139], v2, s[40:43], s70 offen offset:0 nt
    s_waitcnt lgkmcnt(0)
    s_barrier
    ds_read_b128 v[240:243], v15 offset:20032
    ds_read_b128 v[244:247], v15 offset:20048
    s_waitcnt lgkmcnt(0)
    v_max3_f32 v240, v240, v241, v242
    v_max3_f32 v244, v243, v244, v245
    v_max3_f32 v240, v240, v246, v247
    v_max_f32 v248, v240, v244
    s_waitcnt vmcnt(4)
    s_bitcmp1_b32 0xf0, s4
    s_cbranch_scc1 L_y17
    s_waitcnt vmcnt(3)
L_y17:
    buffer_load_dwordx4 v[140:143], v2, s[40:43], s70 offen offset:128 nt
    v_sub_f32 v232, v232, v248
    v_sub_f32 v233, v233, v248
    v_sub_f32 v234, v234, v248
    v_sub_f32 v235, v235, v248
    v_sub_f32 v236, v236, v248
    v_sub_f32 v237, v237, v248
    v_sub_f32 v238, v238, v248
    v_sub_f32 v239, v239, v248
    v_mul_f32 v232, 0x3fb8aa3b, v232
    v_mul_f32 v233, 0x3fb8aa3b, v233
    v_mul_f32 v234, 0x3fb8aa3b, v234
    v_mul_f32 v235, 0x3fb8aa3b, v235
    v_mul_f32 v236, 0x3fb8aa3b, v236
    v_mul_f32 v237, 0x3fb8aa3b, v237
    v_mul_f32 v238, 0x3fb8aa3b, v238
    v_mul_f32 v239, 0x3fb8aa3b, v239
    v_exp_f32 v232, v232
    v_exp_f32 v233, v233
    v_exp_f32 v234, v234
    v_exp_f32 v235, v235
    v_exp_f32 v236, v236
    v_exp_f32 v237, v237
    v_exp_f32 v238, v238
    v_exp_f32 v239, v239
    v_add_f32 v240, v232, v233
    v_add_f32 v241, v234, v235
    v_add_f32 v242, v236, v237
    v_add_f32 v243, v238, v239
    v_add_f32 v240, v240, v241
    v_add_f32 v242, v242, v243
    v_add_f32 v240, v240, v242
    s_nop 1
    v_add_f32_dpp v240, v240, v240 row_ror:8 row_mask:0xf bank_mask:0xf
    v_mov_b32 v241, v240
    s_nop 1
    v_permlane16_swap_b32 v240, v241
    v_add_f32 v240, v240, v241
    v_mov_b32 v241, v240
    s_nop 1
    v_permlane32_swap_b32 v240, v241
    v_add_f32 v240, v240, v241
    s_mov_b64 exec, 1
    ds_write_b32 v14, v240 offset:20064
    s_mov_b64 exec, -1
    v_cvt_pk_bf16_f32 v232, v232, v232
    v_cvt_pk_bf16_f32 v233, v233, v233
    v_cvt_pk_bf16_f32 v234, v234, v234
    v_cvt_pk_bf16_f32 v235, v235, v235
    v_cvt_pk_bf16_f32 v236, v236, v236
    v_cvt_pk_bf16_f32 v237, v237, v237
    v_cvt_pk_bf16_f32 v238, v238, v238
    v_cvt_pk_bf16_f32 v239, v239, v239
    s_waitcnt lgkmcnt(0)
    s_barrier
    s_cmp_lg_u32 s4, 0
    s_cbranch_scc1 L_noml
    ds_read_b128 v[240:243], v15 offset:20064
    ds_read_b128 v[244:247], v15 offset:20080
    s_lshl_b32 s3, s94, 4
    s_add_u32 s3, s3, 851968
    v_mov_b32 v250, s82
    v_mov_b32 v251, v3
    s_waitcnt lgkmcnt(0)
    v_add_f32 v240, v240, v241
    v_add_f32 v242, v242, v243
    v_add_f32 v244, v244, v245
    v_add_f32 v246, v246, v247
    v_add_f32 v240, v240, v242
    v_add_f32 v244, v244, v246
    v_add_f32 v249, v240, v244
    v_lshlrev_b32 v240, 4, v1
    s_mov_b64 exec, 1
    buffer_store_dwordx4 v[248:251], v240, s[52:55], s3 offen sc1
    s_mov_b64 exec, -1
L_noml:
    s_waitcnt vmcnt(4)
    s_bitcmp1_b32 0xf0, s4
    s_cbranch_scc1 L_y18
    s_waitcnt vmcnt(3)
L_y18:
    buffer_load_dwordx4 v[144:147], v2, s[40:43], s70 offen offset:256 nt
    v_lshlrev_b32 v12, 3, v8
    s_lshr_b32 s3, s4, 2
    s_lshl_b32 s3, s3, 1
    s_and_b32 s62, s4, 1
    s_add_u32 s3, s3, s62
    s_and_b32 s62, s4, 2
    s_lshl_b32 s62, s62, 1
    s_add_u32 s3, s3, s62
    v_add_u32 v12, s3, v12
    v_mul_u32_u24 v12, 1280, v12
    v_lshl_add_u32 v109, v9, 2, v12
    v_lshl_add_u32 v108, v9, 4, v12
    s_mov_b32 s97, 81920
    s_mov_b32 s100, 163840
    s_mul_i32 s3, s4, 6
    v_add_u32 v12, s3, v8
    v_mul_u32_u24 v12, 1280, v12
    v_cmp_lt_u32 vcc, 5, v8
    s_nop 1
    v_cndmask_b32 v12, v12, 2.0, vcc
    v_lshl_add_u32 v111, v9, 2, v12
    v_lshl_add_u32 v110, v9, 4, v12
    v_and_b32 v16, v232, v4
    v_and_b32 v17, v232, v5
    v_and_b32 v18, v232, v6
    v_and_b32 v19, v232, v7
    v_and_b32 v20, v233, v4
    v_and_b32 v21, v233, v5
    v_and_b32 v22, v233, v6
    v_and_b32 v23, v233, v7
    v_and_b32 v24, v234, v4
    v_and_b32 v25, v234, v5
    v_and_b32 v26, v234, v6
    v_and_b32 v27, v234, v7
    v_and_b32 v28, v235, v4
    v_and_b32 v29, v235, v5
    v_and_b32 v30, v235, v6
    v_and_b32 v31, v235, v7
    v_and_b32 v32, v236, v4
    v_and_b32 v33, v236, v5
    v_and_b32 v34, v236, v6
    v_and_b32 v35, v236, v7
    v_and_b32 v36, v237, v4
    v_and_b32 v37, v237, v5
    v_and_b32 v38, v237, v6
    v_and_b32 v39, v237, v7
    v_and_b32 v40, v238, v4
    v_and_b32 v41, v238, v5
    v_and_b32 v42, v238, v6
    v_and_b32 v43, v238, v7
    v_and_b32 v44, v239, v4
    v_and_b32 v45, v239, v5
    v_and_b32 v46, v239, v6
    v_and_b32 v47, v239, v7
    s_waitcnt vmcnt(4)
    s_bitcmp1_b32 0xf0, s4
    s_cbranch_scc1 L_y19
    s_waitcnt vmcnt(3)
L_y19:
    buffer_load_dwordx4 v[148:151], v2, s[40:43], s71 offen offset:0 nt
    v_lshlrev_b32 v4, 4, v1
    s_lshl_b32 s3, s4, 10
    v_add_u32 v5, s3, v4
    v_lshlrev_b32 v6, 4, v9
    v_lshlrev_b32 v7, 10, v9
    v_lshl_add_u32 v7, v8, 4, v7
    s_lshl_b32 s3, s4, 7
    v_add_u32 v7, s3, v7
    s_lshl_b32 s95, s5, 7
    s_add_u32 s95, s95, 851968
    s_lshl_b32 s96, s5, 13
    s_add_u32 s96, s96, 917504
    s_lshl_b32 s62, s94, 10
    s_add_u32 s62, s62, 917504
    s_waitcnt vmcnt(4)
    s_bitcmp1_b32 0xf1, s4
    s_cbranch_scc1 L_y20
    s_waitcnt vmcnt(3)
L_y20:
    buffer_load_dwordx4 v[152:155], v2, s[40:43], s71 offen offset:128 nt
    s_mov_b32 s101, 29696
    s_waitcnt vmcnt(8)
    v_mfma_f32_16x16x32_bf16 v[220:223], v[16:19], v[112:115], 0
    v_mfma_f32_16x16x32_bf16 v[224:227], v[16:19], v[116:119], 0
    v_mfma_f32_16x16x32_bf16 v[228:231], v[16:19], v[120:123], 0
    s_waitcnt vmcnt(5)
    v_mfma_f32_16x16x32_bf16 v[220:223], v[20:23], v[124:127], v[220:223]
    v_mfma_f32_16x16x32_bf16 v[224:227], v[20:23], v[128:131], v[224:227]
    v_mfma_f32_16x16x32_bf16 v[228:231], v[20:23], v[132:135], v[228:231]
    s_waitcnt vmcnt(4)
    s_bitcmp1_b32 0xf1, s4
    s_cbranch_scc1 L_y21
    s_waitcnt vmcnt(3)
L_y21:
    buffer_load_dwordx4 v[156:159], v2, s[40:43], s71 offen offset:256 nt
    s_waitcnt vmcnt(3)
    buffer_load_dwordx4 v[160:163], v2, s[40:43], s72 offen offset:0 nt
    v_mfma_f32_16x16x32_bf16 v[220:223], v[24:27], v[136:139], v[220:223]
    v_mfma_f32_16x16x32_bf16 v[224:227], v[24:27], v[140:143], v[224:227]
    v_mfma_f32_16x16x32_bf16 v[228:231], v[24:27], v[144:147], v[228:231]
    s_waitcnt vmcnt(4)
    s_bitcmp1_b32 0xf1, s4
    s_cbranch_scc1 L_y22
    s_waitcnt vmcnt(3)
L_y22:
    buffer_load_dwordx4 v[164:167], v2, s[40:43], s72 offen offset:128 nt
    s_waitcnt vmcnt(4)
    s_bitcmp1_b32 0xf1, s4
    s_cbranch_scc1 L_y23
    s_waitcnt vmcnt(3)
L_y23:
    buffer_load_dwordx4 v[168:171], v2, s[40:43], s72 offen offset:256 nt
    s_waitcnt vmcnt(3)
    buffer_load_dwordx4 v[172:175], v2, s[40:43], s73 offen offset:0 nt
    v_mfma_f32_16x16x32_bf16 v[220:223], v[28:31], v[148:151], v[220:223]
    v_mfma_f32_16x16x32_bf16 v[224:227], v[28:31], v[152:155], v[224:227]
    v_mfma_f32_16x16x32_bf16 v[228:231], v[28:31], v[156:159], v[228:231]
    s_waitcnt vmcnt(4)
    s_bitcmp1_b32 0xf1, s4
    s_cbranch_scc1 L_y24
    s_waitcnt vmcnt(3)
L_y24:
    buffer_load_dwordx4 v[176:179], v2, s[40:43], s73 offen offset:128 nt
    buffer_load_dwordx4 v[48:51], v108, s[44:47], 0 offen
    buffer_load_dword v64, v109, s[44:47], 0 offen offset:128
    buffer_load_dwordx4 v[52:55], v108, s[44:47], s97 offen
    buffer_load_dword v65, v109, s[44:47], s97 offen offset:128
    buffer_load_dwordx4 v[56:59], v108, s[44:47], s100 offen
    buffer_load_dword v66, v109, s[44:47], s100 offen offset:128
    buffer_load_dwordx4 v[60:63], v110, s[48:51], 0 offen
    buffer_load_dword v67, v111, s[48:51], 0 offen offset:128
    s_waitcnt vmcnt(12)
    s_bitcmp1_b32 0xf1, s4
    s_cbranch_scc1 L_y25
    s_waitcnt vmcnt(11)
L_y25:
    buffer_load_dwordx4 v[180:183], v2, s[40:43], s73 offen offset:256 nt
    s_waitcnt vmcnt(11)
    buffer_load_dwordx4 v[184:187], v2, s[40:43], s74 offen offset:0 nt
    v_mfma_f32_16x16x32_bf16 v[220:223], v[32:35], v[160:163], v[220:223]
    v_mfma_f32_16x16x32_bf16 v[224:227], v[32:35], v[164:167], v[224:227]
    v_mfma_f32_16x16x32_bf16 v[228:231], v[32:35], v[168:171], v[228:231]
    s_waitcnt vmcnt(12)
    s_bitcmp1_b32 0xf1, s4
    s_cbranch_scc1 L_y26
    s_waitcnt vmcnt(11)
L_y26:
    buffer_load_dwordx4 v[188:191], v2, s[40:43], s74 offen offset:128 nt
    s_waitcnt vmcnt(12)
    s_bitcmp1_b32 0xf1, s4
    s_cbranch_scc1 L_y27
    s_waitcnt vmcnt(11)
L_y27:
    buffer_load_dwordx4 v[192:195], v2, s[40:43], s74 offen offset:256 nt
    s_waitcnt vmcnt(3)
    buffer_load_dwordx4 v[196:199], v2, s[40:43], s75 offen offset:0 nt
    v_mfma_f32_16x16x32_bf16 v[220:223], v[36:39], v[172:175], v[220:223]
    v_mfma_f32_16x16x32_bf16 v[224:227], v[36:39], v[176:179], v[224:227]
    v_mfma_f32_16x16x32_bf16 v[228:231], v[36:39], v[180:183], v[228:231]
    s_waitcnt vmcnt(4)
    s_bitcmp1_b32 0xf1, s4
    s_cbranch_scc1 L_y28
    s_waitcnt vmcnt(3)
L_y28:
    buffer_load_dwordx4 v[200:203], v2, s[40:43], s75 offen offset:128 nt
    s_waitcnt vmcnt(4)
    s_bitcmp1_b32 0xf1, s4
    s_cbranch_scc1 L_y29
    s_waitcnt vmcnt(3)
L_y29:
    buffer_load_dwordx4 v[204:207], v2, s[40:43], s75 offen offset:256 nt
    buffer_load_dwordx4 v[216:219], v6, s[52:55], s95 offen sc1
    s_waitcnt vmcnt(8)
    v_perm_b32 v68, v52, v48, s92
    v_perm_b32 v88, v52, v48, s92
    v_perm_b32 v70, v54, v50, s93
    v_perm_b32 v69, v60, v56, s92
    v_perm_b32 v89, v60, v56, s92
    v_perm_b32 v71, v62, v58, s93
    v_perm_b32 v72, v52, v48, s93
    v_perm_b32 v90, v52, v48, s93
    v_perm_b32 v74, v55, v51, s92
    v_perm_b32 v73, v60, v56, s93
    v_perm_b32 v91, v60, v56, s93
    v_perm_b32 v75, v63, v59, s92
    v_perm_b32 v76, v53, v49, s92
    v_perm_b32 v92, v53, v49, s92
    v_perm_b32 v78, v55, v51, s93
    v_perm_b32 v77, v61, v57, s92
    v_perm_b32 v93, v61, v57, s92
    v_perm_b32 v79, v63, v59, s93
    v_perm_b32 v80, v53, v49, s93
    v_perm_b32 v94, v53, v49, s93
    v_perm_b32 v82, v65, v64, s92
    v_perm_b32 v81, v61, v57, s93
    v_perm_b32 v95, v61, v57, s93
    v_perm_b32 v83, v67, v66, s92
    v_perm_b32 v84, v54, v50, s92
    v_perm_b32 v96, v54, v50, s92
    v_perm_b32 v86, v65, v64, s93
    v_perm_b32 v85, v62, v58, s92
    v_perm_b32 v97, v62, v58, s92
    v_perm_b32 v87, v67, v66, s93
    v_mov_b32_dpp v68, v70 row_ror:8 row_mask:0xf bank_mask:0xc
    v_mov_b32_dpp v69, v71 row_ror:8 row_mask:0xf bank_mask:0xc
    v_mov_b32_dpp v72, v74 row_ror:8 row_mask:0xf bank_mask:0xc
    v_mov_b32_dpp v73, v75 row_ror:8 row_mask:0xf bank_mask:0xc
    v_mov_b32_dpp v76, v78 row_ror:8 row_mask:0xf bank_mask:0xc
    v_mov_b32_dpp v77, v79 row_ror:8 row_mask:0xf bank_mask:0xc
    v_mov_b32_dpp v80, v82 row_ror:8 row_mask:0xf bank_mask:0xc
    v_mov_b32_dpp v81, v83 row_ror:8 row_mask:0xf bank_mask:0xc
    v_mov_b32_dpp v84, v86 row_ror:8 row_mask:0xf bank_mask:0xc
    v_mov_b32_dpp v85, v87 row_ror:8 row_mask:0xf bank_mask:0xc
    v_mov_b32_dpp v70, v88 row_ror:8 row_mask:0xf bank_mask:0x3
    v_mov_b32_dpp v71, v89 row_ror:8 row_mask:0xf bank_mask:0x3
    v_mov_b32_dpp v74, v90 row_ror:8 row_mask:0xf bank_mask:0x3
    v_mov_b32_dpp v75, v91 row_ror:8 row_mask:0xf bank_mask:0x3
    v_mov_b32_dpp v78, v92 row_ror:8 row_mask:0xf bank_mask:0x3
    v_mov_b32_dpp v79, v93 row_ror:8 row_mask:0xf bank_mask:0x3
    v_mov_b32_dpp v82, v94 row_ror:8 row_mask:0xf bank_mask:0x3
    v_mov_b32_dpp v83, v95 row_ror:8 row_mask:0xf bank_mask:0x3
    v_mov_b32_dpp v86, v96 row_ror:8 row_mask:0xf bank_mask:0x3
    v_mov_b32_dpp v87, v97 row_ror:8 row_mask:0xf bank_mask:0x3
    v_add3_u32 v14, v5, v4, s101
    s_waitcnt vmcnt(4)
    v_mfma_f32_16x16x32_bf16 v[220:223], v[40:43], v[184:187], v[220:223]
    v_mfma_f32_16x16x32_bf16 v[224:227], v[40:43], v[188:191], v[224:227]
    v_mfma_f32_16x16x32_bf16 v[228:231], v[40:43], v[192:195], v[228:231]
    s_waitcnt vmcnt(1)
    v_mfma_f32_16x16x32_bf16 v[220:223], v[44:47], v[196:199], v[220:223]
    v_mfma_f32_16x16x32_bf16 v[224:227], v[44:47], v[200:203], v[224:227]
    v_mfma_f32_16x16x32_bf16 v[228:231], v[44:47], v[204:207], v[228:231]
    s_nop 5
    v_permlane32_swap_b32 v220, v222
    v_permlane32_swap_b32 v221, v223
    v_permlane32_swap_b32 v224, v226
    v_permlane32_swap_b32 v225, v227
    v_permlane32_swap_b32 v228, v230
    v_permlane32_swap_b32 v229, v231
    v_add_f32_dpp v240, v222, v220 row_ror:8 row_mask:0xf bank_mask:0x3
    v_add_f32_dpp v241, v226, v224 row_ror:8 row_mask:0xf bank_mask:0x3
    v_add_f32_dpp v242, v230, v228 row_ror:8 row_mask:0xf bank_mask:0x3
    v_add_f32_dpp v240, v221, v223 row_ror:8 row_mask:0xf bank_mask:0xc
    v_add_f32_dpp v241, v225, v227 row_ror:8 row_mask:0xf bank_mask:0xc
    v_add_f32_dpp v242, v229, v231 row_ror:8 row_mask:0xf bank_mask:0xc
    ds_write_b128 v5, v[240:243] offset:20480
    s_waitcnt lgkmcnt(0)
    s_barrier
    s_cmp_lg_u32 s4, 0
    s_cbranch_scc1 L_nopub1
    ds_read_b128 v[112:115], v4 offset:20480
    ds_read_b128 v[116:119], v4 offset:21504
    ds_read_b128 v[120:123], v4 offset:22528
    ds_read_b128 v[124:127], v4 offset:23552
    ds_read_b128 v[128:131], v4 offset:24576
    ds_read_b128 v[132:135], v4 offset:25600
    ds_read_b128 v[136:139], v4 offset:26624
    ds_read_b128 v[140:143], v4 offset:27648
    s_waitcnt vmcnt(0)
L_chkml:
    v_cmp_ne_u32 vcc, v219, v3
    s_cbranch_vccz L_okml
    s_mov_b64 exec, vcc
    buffer_load_dwordx4 v[216:219], v6, s[52:55], s95 offen sc1
    s_mov_b64 exec, -1
    s_waitcnt vmcnt(0)
    s_sub_u32 s89, s89, 1
    s_cbranch_scc1 L_end
    s_branch L_chkml
L_okml:
    v_cmp_ne_u32 vcc, s82, v218
    s_cmp_eq_u64 vcc, 0
    s_cselect_b32 s83, 1, 0
    v_mov_b32 v147, v3
    s_waitcnt lgkmcnt(6)
    v_pk_add_f32 v[112:113], v[112:113], v[116:117]
    v_add_f32 v114, v114, v118
    s_waitcnt lgkmcnt(5)
    v_pk_add_f32 v[112:113], v[112:113], v[120:121]
    v_add_f32 v114, v114, v122
    s_waitcnt lgkmcnt(4)
    v_pk_add_f32 v[112:113], v[112:113], v[124:125]
    v_add_f32 v114, v114, v126
    s_waitcnt lgkmcnt(3)
    v_pk_add_f32 v[112:113], v[112:113], v[128:129]
    v_add_f32 v114, v114, v130
    s_waitcnt lgkmcnt(2)
    v_pk_add_f32 v[112:113], v[112:113], v[132:133]
    v_add_f32 v114, v114, v134
    s_waitcnt lgkmcnt(1)
    v_pk_add_f32 v[112:113], v[112:113], v[136:137]
    v_add_f32 v114, v114, v138
    s_waitcnt lgkmcnt(0)
    v_pk_add_f32 v[144:145], v[112:113], v[140:141]
    v_add_f32 v146, v114, v142
    s_cmp_eq_u32 s83, 0
    s_cbranch_scc1 L_p1far
    buffer_store_dwordx4 v[144:147], v4, s[52:55], s62 offen
    s_branch L_nopub1
L_p1far:
    buffer_store_dwordx4 v[144:147], v4, s[52:55], s62 offen sc1
L_nopub1:
    buffer_load_dwordx4 v[244:247], v7, s[52:55], s96 offen sc1
    s_waitcnt vmcnt(1)
L_chkml2:
    v_cmp_ne_u32 vcc, v219, v3
    s_cbranch_vccz L_okml2
    s_mov_b64 exec, vcc
    buffer_load_dwordx4 v[216:219], v6, s[52:55], s95 offen sc1
    s_mov_b64 exec, -1
    s_waitcnt vmcnt(0)
    s_sub_u32 s89, s89, 1
    s_cbranch_scc1 L_end
    s_branch L_chkml2
L_okml2:
    v_max_f32_dpp v12, v216, v216 quad_perm:[1,0,3,2] row_mask:0xf bank_mask:0xf
    s_nop 1
    v_max_f32_dpp v12, v12, v12 quad_perm:[2,3,0,1] row_mask:0xf bank_mask:0xf
    v_sub_f32 v12, v216, v12
    v_mul_f32 v12, 0x3fb8aa3b, v12
    v_exp_f32 v12, v12
    s_nop 0
    v_mul_f32 v13, v12, v217
    s_nop 1
    v_add_f32_dpp v13, v13, v13 quad_perm:[1,0,3,2] row_mask:0xf bank_mask:0xf
    s_nop 1
    v_add_f32_dpp v13, v13, v13 quad_perm:[2,3,0,1] row_mask:0xf bank_mask:0xf
    v_rcp_f32 v13, v13
    v_mul_f32 v12, v12, v11
    v_mul_f32 v12, v12, v13
    s_waitcnt vmcnt(0)
L_chk1:
    v_cmp_ne_u32 vcc, v247, v3
    s_cbranch_vccz L_ok1
    s_mov_b64 exec, vcc
    buffer_load_dwordx4 v[244:247], v7, s[52:55], s96 offen sc1
    s_mov_b64 exec, -1
    s_waitcnt vmcnt(0)
    s_sub_u32 s89, s89, 1
    s_cbranch_scc1 L_end
    s_branch L_chk1
L_ok1:
    v_mul_f32 v244, v244, v12
    v_mul_f32 v245, v245, v12
    v_mul_f32 v246, v246, v12
    v_add_f32_dpp v244, v244, v244 quad_perm:[1,0,3,2] row_mask:0xf bank_mask:0xf
    v_add_f32_dpp v245, v245, v245 quad_perm:[1,0,3,2] row_mask:0xf bank_mask:0xf
    v_add_f32_dpp v246, v246, v246 quad_perm:[1,0,3,2] row_mask:0xf bank_mask:0xf
    v_add_f32_dpp v244, v244, v244 quad_perm:[2,3,0,1] row_mask:0xf bank_mask:0xf
    v_add_f32_dpp v245, v245, v245 quad_perm:[2,3,0,1] row_mask:0xf bank_mask:0xf
    v_add_f32_dpp v246, v246, v246 quad_perm:[2,3,0,1] row_mask:0xf bank_mask:0xf
    v_cvt_pk_bf16_f32 v240, v244, v245
    v_cvt_pk_bf16_f32 v241, v246, v10
    s_nop 0
    v_mov_b32_dpp v242, v240 row_ror:8 row_mask:0xf bank_mask:0xf
    v_mov_b32_dpp v243, v241 row_ror:8 row_mask:0xf bank_mask:0xf
    s_nop 1
    v_mfma_f32_16x16x32_bf16 v[88:91], v[240:243], v[68:71], 0
    v_mfma_f32_16x16x32_bf16 v[92:95], v[240:243], v[72:75], 0
    v_mfma_f32_16x16x32_bf16 v[96:99], v[240:243], v[76:79], 0
    v_mfma_f32_16x16x32_bf16 v[100:103], v[240:243], v[80:83], 0
    v_mfma_f32_16x16x32_bf16 v[104:107], v[240:243], v[84:87], 0
    s_mov_b32 exec_hi, 0
    s_nop 3
    ds_write2_b32 v14, v88, v92 offset0:0 offset1:1
    s_nop 0
    ds_write2_b32 v14, v96, v100 offset0:2 offset1:4
    ds_write_b32 v14, v104 offset:20
    s_mov_b32 exec_hi, -1
    s_lshl_b32 s3, s6, 15
    s_add_u32 s96, s3, 1179648
    s_lshl_b32 s3, s5, 10
    s_add_u32 s76, s96, s3
    v_lshrrev_b32 v6, 1, v1
    v_lshlrev_b32 v6, 10, v6
    v_and_b32 v7, 1, v1
    v_lshl_add_u32 v6, v7, 4, v6
    s_lshl_b32 s3, s5, 5
    v_add_u32 v6, s3, v6
    s_waitcnt lgkmcnt(0)
    s_barrier
    s_cmp_lg_u32 s4, 0
    s_cbranch_scc1 L_nopub2
    ds_read_b128 v[112:115], v4 offset:29696
    ds_read_b128 v[116:119], v4 offset:30720
    ds_read_b128 v[120:123], v4 offset:31744
    ds_read_b128 v[124:127], v4 offset:32768
    ds_read_b128 v[128:131], v4 offset:33792
    ds_read_b128 v[132:135], v4 offset:34816
    ds_read_b128 v[136:139], v4 offset:35840
    ds_read_b128 v[140:143], v4 offset:36864
    v_mov_b32 v147, v3
    s_mov_b32 s62, s76
    s_waitcnt lgkmcnt(6)
    v_pk_add_f32 v[112:113], v[112:113], v[116:117]
    v_add_f32 v114, v114, v118
    s_waitcnt lgkmcnt(5)
    v_pk_add_f32 v[112:113], v[112:113], v[120:121]
    v_add_f32 v114, v114, v122
    s_waitcnt lgkmcnt(4)
    v_pk_add_f32 v[112:113], v[112:113], v[124:125]
    v_add_f32 v114, v114, v126
    s_waitcnt lgkmcnt(3)
    v_pk_add_f32 v[112:113], v[112:113], v[128:129]
    v_add_f32 v114, v114, v130
    s_waitcnt lgkmcnt(2)
    v_pk_add_f32 v[112:113], v[112:113], v[132:133]
    v_add_f32 v114, v114, v134
    s_waitcnt lgkmcnt(1)
    v_pk_add_f32 v[112:113], v[112:113], v[136:137]
    v_add_f32 v114, v114, v138
    s_waitcnt lgkmcnt(0)
    v_pk_add_f32 v[144:145], v[112:113], v[140:141]
    v_add_f32 v146, v114, v142
    buffer_store_dwordx4 v[144:147], v4, s[52:55], s62 offen sc1
L_nopub2:
    s_bitcmp0_b32 0x2, s4
    s_cbranch_scc1 L_wave_done
    buffer_load_dwordx4 v[244:247], v6, s[52:55], s96 offen sc1
    s_lshr_b32 s76, s5, 3
    s_and_b32 s76, s76, 1
    s_mul_i32 s76, s76, 5
    s_lshr_b32 s78, s5, 4
    s_mul_i32 s78, s78, 640
    s_mul_i32 s79, s6, 80
    s_add_u32 s78, s78, s79
    s_and_b32 s79, s5, 7
    v_lshrrev_b32 v9, 5, v1
    v_bfe_u32 v13, v1, 4, 1
    v_lshl_add_u32 v9, v13, 1, v9
    v_mad_u32_u24 v9, v7, 3, v9
    v_add_u32 v9, s76, v9
    v_mov_b32 v8, s79
    v_lshl_add_u32 v12, v8, 3, v9
    v_lshl_add_u32 v13, v8, 1, v9
    v_add_u32 v13, 56, v13
    v_cmp_lt_u32 vcc, 7, v9
    s_nop 1
    v_cndmask_b32 v12, v12, v13, vcc
    v_add_lshl_u32 v12, s78, v12, 1
    s_mov_b32 s85, 0x10003
    s_waitcnt vmcnt(0)
L_chk2:
    v_cmp_ne_u32 vcc, v247, v3
    s_cbranch_vccz L_ok2
    s_mov_b64 exec, vcc
    buffer_load_dwordx4 v[244:247], v6, s[52:55], s96 offen sc1
    s_mov_b64 exec, -1
    s_waitcnt vmcnt(0)
    s_sub_u32 s89, s89, 1
    s_cbranch_scc1 L_end
    s_branch L_chk2
L_ok2:
    v_mov_b32 v247, v246
    v_permlane32_swap_b32 v244, v245
    s_nop 0
    v_permlane32_swap_b32 v246, v247
    v_add_f32 v244, v244, v245
    v_add_f32 v246, v246, v247
    s_nop 1
    v_permlane16_swap_b32 v244, v246
    v_add_f32 v244, v244, v246
    s_nop 1
    v_add_f32_dpp v244, v244, v244 row_ror:8 row_mask:0xf bank_mask:0xf
    s_nop 1
    v_add_f32_dpp v244, v244, v244 row_ror:4 row_mask:0xf bank_mask:0xf
    s_nop 1
    v_add_f32_dpp v244, v244, v244 quad_perm:[2,3,0,1] row_mask:0xf bank_mask:0xf
    v_cvt_pk_bf16_f32 v244, v244, v244
    s_mov_b32 exec_lo, s85
    s_mov_b32 exec_hi, 3
    buffer_store_short v244, v12, s[56:59], 0 offen
    s_cmp_lg_u32 s2, 0
    s_cbranch_scc1 L_wave_done
    s_mov_b64 exec, 1
    buffer_store_dword v3, off, s[52:55], 0 sc1
L_wave_done:
L_end:
    s_endpgm
.section .rodata,"a"
.p2align 6
.amdhsa_kernel gated_mix__sliding_block_cached__swiglu_ffn__decode_kernel
  .amdhsa_next_free_vgpr 256
  .amdhsa_next_free_sgpr 102
  .amdhsa_accum_offset 256
  .amdhsa_group_segment_fixed_size 0
  .amdhsa_kernarg_size 104
  .amdhsa_user_sgpr_count 2
  .amdhsa_user_sgpr_kernarg_segment_ptr 1
  .amdhsa_system_sgpr_workgroup_id_x 1
  .amdhsa_float_denorm_mode_32 3
.end_amdhsa_kernel
```
